```python
import torch

def _softmax(x, axis=-1):
    return torch.softmax(x, dim=axis)
def _gelu(x):
    return torch.nn.functional.gelu(x, approximate="tanh")
def _silu(x):
    return torch.nn.functional.silu(x)
def _sigmoid(x):
    return torch.sigmoid(x)
def _layernorm(x, axis=-1, eps=1e-5):
    m = x.mean(dim=axis, keepdim=True)
    v = x.var(dim=axis, keepdim=True, unbiased=False)
    return (x - m) / torch.sqrt(v + eps)
def _scatter_add(tgt, idx, src, axis=0):
    return tgt.clone().index_add_(axis, idx, src)
def _segment_sum(src, seg, n):
    out = torch.zeros((n,) + src.shape[1:], dtype=src.dtype)
    return out.index_add_(0, seg, src)
def _pad(x, pw):
    flat = tuple(v for pair in reversed(pw) for v in pair)
    return torch.nn.functional.pad(x, flat)

kernel_name = 'parallel_sum__sliding_block_cached__glu_gated_glu__decode'

def setup_inputs():

    _w = (lambda a: (lambda t: t.to(torch.bfloat16) if t.is_floating_point() else t)(torch.as_tensor(a)))
    def _A_setup():
        B, Sq, D = 1, 1, 640
        Hq, Hkv, Sk, Dh = 32, 32, 32768, 128
        assert Hq % Hkv == 0, (Hq, Hkv)
        return {
            "x": _w((lambda *s: torch.randn(*s, dtype=torch.bfloat16) * 0.05)(B, Sq, D)),
            "k_cache": _w((lambda *s: torch.randn(*s, dtype=torch.bfloat16) * 3.2)(B, Hkv, Sk, Dh)),
            "v_cache": _w((lambda *s: torch.randn(*s, dtype=torch.bfloat16) * 1.6)(B, Hkv, Sk, Dh)),
            "wq": _w((lambda *s: torch.randn(*s, dtype=torch.bfloat16) * 3.2)(D, Hq * Dh) * (D ** -0.5)),
            "wo": _w((lambda *s: torch.randn(*s, dtype=torch.bfloat16) * 1.6)(Hq * Dh, D) * ((Hq * Dh) ** -0.5)),
        }
    _A_in = _A_setup()

    def _B_setup():
        B, S, D, F = 1, 1, 640, 1728
        return {
            "x": _w((lambda *s: torch.randn(*s, dtype=torch.bfloat16) * 0.05)(B, S, D)),
            "w_gate": _w((lambda *s: torch.randn(*s, dtype=torch.bfloat16) * 0.2)(D, F)),
            "w_up": _w((lambda *s: torch.randn(*s, dtype=torch.bfloat16) * 0.05)(D, F)),
            "w_down": _w((lambda *s: torch.randn(*s, dtype=torch.bfloat16) * 0.05)(F, D)),
        }
    _B_in = _B_setup()

    return {
        "A_x": _A_in["x"],
        "A_k_cache": _A_in["k_cache"],
        "A_v_cache": _A_in["v_cache"],
        "A_wq": _A_in["wq"],
        "A_wo": _A_in["wo"],
        "B_x": _B_in["x"],
        "B_w_gate": _B_in["w_gate"],
        "B_w_up": _B_in["w_up"],
        "B_w_down": _B_in["w_down"],
    }

def reference(A_x, A_k_cache, A_v_cache, A_wq, A_wo, B_x, B_w_gate, B_w_up, B_w_down):
    def _A_ref(x, k_cache, v_cache, wq, wo):
        B, Sq, D = x.shape
        Hq, Dh = 32, 128
        Hkv, Sk = k_cache.shape[1], k_cache.shape[2]
        W = min(4096, max(256, Sk // 4))
        rep = Hq // Hkv
        q = (lambda x, *d: x.permute(*d))((x @ wq).reshape(B, Sq, Hq, Dh), 0, 2, 1, 3)
        k = (lambda x, n, axis: torch.repeat_interleave(x, n, dim=axis))(k_cache[:, :, Sk - W:, :], rep, axis=1)
        v = (lambda x, n, axis: torch.repeat_interleave(x, n, dim=axis))(v_cache[:, :, Sk - W:, :], rep, axis=1)
        scores = torch.einsum("bhqd,bhkd->bhqk", q, k) * (Dh ** -0.5)
        p = _softmax(scores, axis=-1)
        o = torch.einsum("bhqk,bhkd->bhqd", p, v)
        return (lambda x, *d: x.permute(*d))(o, 0, 2, 1, 3).reshape(B, Sq, Hq * Dh) @ wo

    def _B_ref(x, w_gate, w_up, w_down):
        g = torch.einsum("bsd,df->bsf", x, w_gate)
        u = torch.einsum("bsd,df->bsf", x, w_up)
        h = _sigmoid(g) * u
        return torch.einsum("bsf,fd->bsd", h, w_down)

    x = A_x
    xn = _layernorm(x, axis=-1)
    return x + _A_ref(xn, A_k_cache, A_v_cache, A_wq, A_wo) + _B_ref(xn, B_w_gate, B_w_up, B_w_down)
```

```asm
; @launch grid=(256,1,1) block=(768,1,1) lds=10240
.amdgcn_target "amdgcn-amd-amdhsa--gfx950"
.text
.globl parallel_sum__sliding_block_cached__glu_gated_glu__decode_kernel
.p2align 8
.type parallel_sum__sliding_block_cached__glu_gated_glu__decode_kernel,@function
parallel_sum__sliding_block_cached__glu_gated_glu__decode_kernel:
    s_cmp_ge_u32 s2, 256
    s_cbranch_scc1 L_end
    s_load_dwordx16 s[8:23], s[0:1], 0
    s_load_dwordx8 s[24:31], s[0:1], 64
    v_lshrrev_b32 v1, 6, v0
    s_nop 0
    v_readfirstlane_b32 s3, v1
    v_and_b32 v0, 63, v0
    s_and_b32 s4, s2, 31
    s_lshr_b32 s5, s2, 5
    s_cmp_ge_u32 s3, 4
    s_cbranch_scc1 L_kv
    s_setprio 3
    v_mov_b32 v3, 0
    ds_write_b32 v3, v3
    v_lshrrev_b32 v3, 3, v0
    v_and_b32 v4, 7, v0
    s_cmp_lt_u32 s4, 27
    s_cselect_b32 s61, 2211840, 0
    s_lshl_b32 s59, s4, 8
    s_lshl_b32 s60, s3, 7
    s_add_u32 s59, s59, s60
    s_lshl_b32 s60, s4, 7
    s_movk_i32 s58, 3456
    s_cmp_lt_u32 s3, 2
    s_cselect_b32 s58, 8192, s58
    s_cselect_b32 s59, s59, s60
    s_mul_i32 s62, s5, 80
    s_mul_i32 s62, s62, s58
    s_add_u32 s62, s62, s59
    s_lshl_b32 s63, s58, 3
    v_mul_lo_u32 v5, s58, v3
    v_lshl_add_u32 v5, v4, 4, v5
    v_lshlrev_b32 v7, 4, v0
    v_lshlrev_b32 v29, 1, v3
    s_mul_i32 s64, s5, 160
    s_waitcnt lgkmcnt(0)
    s_barrier
    s_load_dwordx2 s[56:57], s[30:31], 0
    s_mov_b32 s32, s8
    s_mov_b32 s33, s9
    s_mov_b32 s34, 1280
    s_mov_b32 s35, 0x00020000
    s_cmp_eq_u32 s3, 2
    s_cselect_b64 s[36:37], s[20:21], s[22:23]
    s_cmp_lt_u32 s3, 2
    s_cselect_b64 s[36:37], s[14:15], s[36:37]
    s_cselect_b32 s38, 5242880, s61
    s_mov_b32 s39, 0x00020000
    s_cselect_b32 s42, 0, s61
    buffer_load_dwordx4 v[8:11], v7, s[32:35], 0 offen
    buffer_load_dwordx4 v[12:15], v7, s[32:35], 0 offen offset:1024
    buffer_load_dwordx4 v[32:35], v5, s[36:39], s62 offen nt
    s_add_u32 s62, s62, s63
    buffer_load_dwordx4 v[36:39], v5, s[36:39], s62 offen nt
    s_add_u32 s62, s62, s63
    buffer_load_dwordx4 v[40:43], v5, s[36:39], s62 offen nt
    s_add_u32 s62, s62, s63
    buffer_load_dwordx4 v[44:47], v5, s[36:39], s62 offen nt
    s_add_u32 s62, s62, s63
    buffer_load_dwordx4 v[48:51], v5, s[36:39], s62 offen nt
    s_add_u32 s62, s62, s63
    buffer_load_dwordx4 v[52:55], v5, s[36:39], s62 offen nt
    s_add_u32 s62, s62, s63
    buffer_load_dwordx4 v[56:59], v5, s[36:39], s62 offen nt
    s_add_u32 s62, s62, s63
    buffer_load_dwordx4 v[60:63], v5, s[36:39], s62 offen nt
    s_add_u32 s62, s62, s63
    buffer_load_dwordx4 v[64:67], v5, s[36:39], s62 offen nt
    s_add_u32 s62, s62, s63
    buffer_load_dwordx4 v[68:71], v5, s[36:39], s62 offen nt
    buffer_load_ushort v18, v29, s[32:35], s64 offen offset:0
    buffer_load_ushort v19, v29, s[32:35], s64 offen offset:16
    buffer_load_ushort v20, v29, s[32:35], s64 offen offset:32
    buffer_load_ushort v21, v29, s[32:35], s64 offen offset:48
    buffer_load_ushort v22, v29, s[32:35], s64 offen offset:64
    buffer_load_ushort v23, v29, s[32:35], s64 offen offset:80
    buffer_load_ushort v24, v29, s[32:35], s64 offen offset:96
    buffer_load_ushort v25, v29, s[32:35], s64 offen offset:112
    buffer_load_ushort v26, v29, s[32:35], s64 offen offset:128
    buffer_load_ushort v27, v29, s[32:35], s64 offen offset:144
    v_and_b32 v1, 15, v0
    v_lshrrev_b32 v2, 4, v0
    v_mul_u32_u24 v6, 1280, v2
    v_lshl_add_u32 v6, v1, 4, v6
    v_mov_b32 v30, 0x40000000
    v_cmp_gt_u32 vcc, 10, v1
    s_nop 1
    v_cndmask_b32 v6, v30, v6, vcc
    v_lshlrev_b32 v30, 1, v4
    s_lshl_b32 s65, s4, 4
    s_add_u32 s65, s65, s64
    s_mov_b32 s40, s24
    s_mov_b32 s41, s25
    s_mov_b32 s43, 0x00020000
    s_mov_b32 s48, s30
    s_mov_b32 s49, s31
    s_mov_b32 s50, 1073741824
    s_mov_b32 s51, 0x00020000
    s_waitcnt lgkmcnt(0)
    s_mul_i32 s56, s56, 0x9E3779B1
    s_add_u32 s56, s56, 0x7F4A7C15
    s_mul_i32 s57, s57, 0x85EBCA6B
    s_add_u32 s57, s57, 0xC2B2AE35
    s_getreg_b32 s79, hwreg(HW_REG_XCC_ID)
    s_and_b32 s79, s79, 15
    s_lshl_b32 s68, s4, 3
    s_add_u32 s68, s68, s5
    v_mov_b32 v164, s79
    v_mov_b32 v165, 0
    v_mov_b32 v166, s56
    v_mov_b32 v167, s57
    s_lshl_b32 s67, s68, 4
    s_add_u32 s67, s67, 786432
    s_mov_b64 exec, 1
    buffer_store_dwordx4 v[164:167], off, s[48:51], s67 sc1
    s_mov_b64 exec, -1
    v_lshlrev_b32 v17, 4, v4
    s_lshl_b32 s75, s4, 7
    s_add_u32 s75, s75, 786432
    s_mov_b32 s44, s16
    s_mov_b32 s45, s17
    s_mov_b32 s46, 5242880
    s_mov_b32 s47, 0x00020000
    s_mov_b32 s52, s26
    s_mov_b32 s53, s27
    s_mov_b32 s54, 1280
    s_mov_b32 s55, 0x00020000
    buffer_load_ushort v28, v30, s[32:35], s65 offen
    s_lshl_b32 s66, s4, 6
    s_and_b32 s67, s3, 1
    s_lshl_b32 s67, s67, 5
    s_add_u32 s66, s66, s67
    s_mul_i32 s66, s66, 1280
    s_add_u32 s66, s66, s64
    buffer_load_dwordx4 v[72:75], v6, s[40:43], s66 offen nt
    s_add_u32 s66, s66, 5120
    buffer_load_dwordx4 v[76:79], v6, s[40:43], s66 offen nt
    s_add_u32 s66, s66, 5120
    buffer_load_dwordx4 v[80:83], v6, s[40:43], s66 offen nt
    s_add_u32 s66, s66, 5120
    buffer_load_dwordx4 v[84:87], v6, s[40:43], s66 offen nt
    s_add_u32 s66, s66, 5120
    buffer_load_dwordx4 v[88:91], v6, s[40:43], s66 offen nt
    s_add_u32 s66, s66, 5120
    buffer_load_dwordx4 v[92:95], v6, s[40:43], s66 offen nt
    s_add_u32 s66, s66, 5120
    buffer_load_dwordx4 v[96:99], v6, s[40:43], s66 offen nt
    s_add_u32 s66, s66, 5120
    buffer_load_dwordx4 v[100:103], v6, s[40:43], s66 offen nt
    buffer_load_ushort v31, v30, s[52:55], s65 offen
    v_and_b32 v120, 1, v0
    v_cmp_eq_u32 vcc, 1, v120
    v_mov_b32 v121, 0x0c0c0100
    v_mov_b32 v122, 0x01000c0c
    v_cndmask_b32 v121, v121, v122, vcc
    v_mov_b32 v120, 0x0c0c0302
    v_mov_b32 v122, 0x03020c0c
    v_cndmask_b32 v122, v120, v122, vcc
    v_bfe_u32 v120, v0, 1, 2
    v_cmp_eq_u32 vcc, 0, v120
    v_mov_b32 v136, 0x0c0c0c0c
    s_nop 0
    v_cndmask_b32 v136, v136, v121, vcc
    v_mov_b32 v140, 0x0c0c0c0c
    v_cndmask_b32 v140, v140, v122, vcc
    v_cmp_eq_u32 vcc, 1, v120
    v_mov_b32 v137, 0x0c0c0c0c
    s_nop 0
    v_cndmask_b32 v137, v137, v121, vcc
    v_mov_b32 v141, 0x0c0c0c0c
    v_cndmask_b32 v141, v141, v122, vcc
    v_cmp_eq_u32 vcc, 2, v120
    v_mov_b32 v138, 0x0c0c0c0c
    s_nop 0
    v_cndmask_b32 v138, v138, v121, vcc
    v_mov_b32 v142, 0x0c0c0c0c
    v_cndmask_b32 v142, v142, v122, vcc
    v_cmp_eq_u32 vcc, 3, v120
    v_mov_b32 v139, 0x0c0c0c0c
    s_nop 0
    v_cndmask_b32 v139, v139, v121, vcc
    v_mov_b32 v143, 0x0c0c0c0c
    v_cndmask_b32 v143, v143, v122, vcc
    s_waitcnt vmcnt(31)
    buffer_load_dwordx4 v[164:167], v17, s[48:51], s75 offen sc1
    v_lshlrev_b32 v104, 16, v8
    v_and_b32 v105, 0xffff0000, v8
    v_lshlrev_b32 v106, 16, v9
    v_and_b32 v107, 0xffff0000, v9
    v_lshlrev_b32 v108, 16, v10
    v_and_b32 v109, 0xffff0000, v10
    v_lshlrev_b32 v110, 16, v11
    v_and_b32 v111, 0xffff0000, v11
    v_lshlrev_b32 v112, 16, v12
    v_and_b32 v113, 0xffff0000, v12
    v_lshlrev_b32 v114, 16, v13
    v_and_b32 v115, 0xffff0000, v13
    v_lshlrev_b32 v116, 16, v14
    v_and_b32 v117, 0xffff0000, v14
    v_lshlrev_b32 v118, 16, v15
    v_and_b32 v119, 0xffff0000, v15
    v_add_f32 v120, v104, v105
    v_add_f32 v120, v120, v106
    v_add_f32 v120, v120, v107
    v_add_f32 v120, v120, v108
    v_add_f32 v120, v120, v109
    v_add_f32 v120, v120, v110
    v_add_f32 v120, v120, v111
    v_add_f32 v120, v120, v112
    v_add_f32 v120, v120, v113
    v_add_f32 v120, v120, v114
    v_add_f32 v120, v120, v115
    v_add_f32 v120, v120, v116
    v_add_f32 v120, v120, v117
    v_add_f32 v120, v120, v118
    v_add_f32 v120, v120, v119
    s_nop 1
    v_add_f32_dpp v120, v120, v120 row_ror:8 row_mask:0xf bank_mask:0xf
    s_nop 1
    v_add_f32_dpp v120, v120, v120 row_ror:4 row_mask:0xf bank_mask:0xf
    s_nop 1
    v_add_f32_dpp v120, v120, v120 row_ror:2 row_mask:0xf bank_mask:0xf
    s_nop 1
    v_add_f32_dpp v120, v120, v120 row_ror:1 row_mask:0xf bank_mask:0xf
    v_mov_b32 v126, v120
    s_nop 1
    v_permlane16_swap_b32 v120, v126
    v_add_f32 v120, v120, v126
    v_mov_b32 v126, v120
    s_nop 1
    v_permlane32_swap_b32 v120, v126
    v_add_f32 v120, v120, v126
    v_mul_f32 v121, 0x3acccccd, v120
    v_cvt_pk_bf16_f32 v122, v121, v121
    v_and_b32 v122, 0xffff0000, v122
    v_sub_f32 v104, v104, v121
    v_sub_f32 v105, v105, v121
    v_sub_f32 v106, v106, v121
    v_sub_f32 v107, v107, v121
    v_sub_f32 v108, v108, v121
    v_sub_f32 v109, v109, v121
    v_sub_f32 v110, v110, v121
    v_sub_f32 v111, v111, v121
    v_sub_f32 v112, v112, v121
    v_sub_f32 v113, v113, v121
    v_sub_f32 v114, v114, v121
    v_sub_f32 v115, v115, v121
    v_sub_f32 v116, v116, v121
    v_sub_f32 v117, v117, v121
    v_sub_f32 v118, v118, v121
    v_sub_f32 v119, v119, v121
    v_mul_f32 v123, v104, v104
    v_fmac_f32 v123, v105, v105
    v_fmac_f32 v123, v106, v106
    v_fmac_f32 v123, v107, v107
    v_fmac_f32 v123, v108, v108
    v_fmac_f32 v123, v109, v109
    v_fmac_f32 v123, v110, v110
    v_fmac_f32 v123, v111, v111
    s_mov_b64 exec, 0xffff
    v_fmac_f32 v123, v112, v112
    v_fmac_f32 v123, v113, v113
    v_fmac_f32 v123, v114, v114
    v_fmac_f32 v123, v115, v115
    v_fmac_f32 v123, v116, v116
    v_fmac_f32 v123, v117, v117
    v_fmac_f32 v123, v118, v118
    v_fmac_f32 v123, v119, v119
    s_mov_b64 exec, -1
    s_nop 0
    v_add_f32_dpp v123, v123, v123 row_ror:8 row_mask:0xf bank_mask:0xf
    s_nop 1
    v_add_f32_dpp v123, v123, v123 row_ror:4 row_mask:0xf bank_mask:0xf
    s_nop 1
    v_add_f32_dpp v123, v123, v123 row_ror:2 row_mask:0xf bank_mask:0xf
    s_nop 1
    v_add_f32_dpp v123, v123, v123 row_ror:1 row_mask:0xf bank_mask:0xf
    v_mov_b32 v126, v123
    s_nop 1
    v_permlane16_swap_b32 v123, v126
    v_add_f32 v123, v123, v126
    v_mov_b32 v126, v123
    s_nop 1
    v_permlane32_swap_b32 v123, v126
    v_add_f32 v123, v123, v126
    v_mul_f32 v123, 0x3acccccd, v123
    v_cvt_pk_bf16_f32 v123, v123, v123
    v_and_b32 v123, 0xffff0000, v123
    v_add_f32 v123, 0x3727c5ac, v123
    v_cvt_pk_bf16_f32 v123, v123, v123
    v_and_b32 v123, 0xffff0000, v123
    v_sqrt_f32 v124, v123
    s_nop 0
    v_cvt_pk_bf16_f32 v124, v124, v124
    v_and_b32 v124, 0xffff0000, v124
    v_rcp_f32 v125, v124
    s_nop 0
    v_fma_f32 v126, -v124, v125, 1.0
    v_fma_f32 v125, v126, v125, v125
    s_waitcnt vmcnt(12)
    buffer_load_dwordx4 v[160:163], v17, s[48:51], s75 offen sc1
    v_lshlrev_b32 v18, 16, v18
    v_sub_f32 v18, v18, v122
    v_cvt_pk_bf16_f32 v18, v18, v18
    v_and_b32 v18, 0xffff0000, v18
    v_mul_f32 v104, v18, v125
    v_fma_f32 v105, -v104, v124, v18
    v_fma_f32 v104, v105, v125, v104
    v_cvt_pk_bf16_f32 v18, v104, v104
    v_lshlrev_b32 v19, 16, v19
    v_sub_f32 v19, v19, v122
    v_cvt_pk_bf16_f32 v19, v19, v19
    v_and_b32 v19, 0xffff0000, v19
    v_mul_f32 v106, v19, v125
    v_fma_f32 v107, -v106, v124, v19
    v_fma_f32 v106, v107, v125, v106
    v_cvt_pk_bf16_f32 v19, v106, v106
    v_lshlrev_b32 v20, 16, v20
    v_sub_f32 v20, v20, v122
    v_cvt_pk_bf16_f32 v20, v20, v20
    v_and_b32 v20, 0xffff0000, v20
    v_mul_f32 v108, v20, v125
    v_fma_f32 v109, -v108, v124, v20
    v_fma_f32 v108, v109, v125, v108
    v_cvt_pk_bf16_f32 v20, v108, v108
    v_lshlrev_b32 v21, 16, v21
    v_sub_f32 v21, v21, v122
    v_cvt_pk_bf16_f32 v21, v21, v21
    v_and_b32 v21, 0xffff0000, v21
    v_mul_f32 v110, v21, v125
    v_fma_f32 v111, -v110, v124, v21
    v_fma_f32 v110, v111, v125, v110
    v_cvt_pk_bf16_f32 v21, v110, v110
    v_lshlrev_b32 v22, 16, v22
    v_sub_f32 v22, v22, v122
    v_cvt_pk_bf16_f32 v22, v22, v22
    v_and_b32 v22, 0xffff0000, v22
    v_mul_f32 v112, v22, v125
    v_fma_f32 v113, -v112, v124, v22
    v_fma_f32 v112, v113, v125, v112
    v_cvt_pk_bf16_f32 v22, v112, v112
    v_lshlrev_b32 v23, 16, v23
    v_sub_f32 v23, v23, v122
    v_cvt_pk_bf16_f32 v23, v23, v23
    v_and_b32 v23, 0xffff0000, v23
    v_mul_f32 v114, v23, v125
    v_fma_f32 v115, -v114, v124, v23
    v_fma_f32 v114, v115, v125, v114
    v_cvt_pk_bf16_f32 v23, v114, v114
    v_lshlrev_b32 v24, 16, v24
    v_sub_f32 v24, v24, v122
    v_cvt_pk_bf16_f32 v24, v24, v24
    v_and_b32 v24, 0xffff0000, v24
    v_mul_f32 v116, v24, v125
    v_fma_f32 v117, -v116, v124, v24
    v_fma_f32 v116, v117, v125, v116
    v_cvt_pk_bf16_f32 v24, v116, v116
    v_lshlrev_b32 v25, 16, v25
    v_sub_f32 v25, v25, v122
    v_cvt_pk_bf16_f32 v25, v25, v25
    v_and_b32 v25, 0xffff0000, v25
    v_mul_f32 v118, v25, v125
    v_fma_f32 v119, -v118, v124, v25
    v_fma_f32 v118, v119, v125, v118
    v_cvt_pk_bf16_f32 v25, v118, v118
    v_lshlrev_b32 v26, 16, v26
    v_sub_f32 v26, v26, v122
    v_cvt_pk_bf16_f32 v26, v26, v26
    v_and_b32 v26, 0xffff0000, v26
    v_mul_f32 v104, v26, v125
    v_fma_f32 v105, -v104, v124, v26
    v_fma_f32 v104, v105, v125, v104
    v_cvt_pk_bf16_f32 v26, v104, v104
    v_lshlrev_b32 v27, 16, v27
    v_sub_f32 v27, v27, v122
    v_cvt_pk_bf16_f32 v27, v27, v27
    v_and_b32 v27, 0xffff0000, v27
    v_mul_f32 v106, v27, v125
    v_fma_f32 v107, -v106, v124, v27
    v_fma_f32 v106, v107, v125, v106
    v_cvt_pk_bf16_f32 v27, v106, v106
    v_perm_b32 v144, v18, v18, v136
    v_perm_b32 v145, v18, v18, v137
    v_perm_b32 v146, v18, v18, v138
    v_perm_b32 v147, v18, v18, v139
    s_nop 1
    v_mfma_f32_16x16x32_bf16 v[152:155], v[144:147], v[32:35], 0
    v_perm_b32 v148, v19, v19, v136
    v_perm_b32 v149, v19, v19, v137
    v_perm_b32 v150, v19, v19, v138
    v_perm_b32 v151, v19, v19, v139
    s_nop 1
    v_mfma_f32_16x16x32_bf16 v[152:155], v[148:151], v[36:39], v[152:155]
    v_perm_b32 v144, v20, v20, v136
    v_perm_b32 v145, v20, v20, v137
    v_perm_b32 v146, v20, v20, v138
    v_perm_b32 v147, v20, v20, v139
    s_nop 1
    v_mfma_f32_16x16x32_bf16 v[152:155], v[144:147], v[40:43], v[152:155]
    v_perm_b32 v148, v21, v21, v136
    v_perm_b32 v149, v21, v21, v137
    v_perm_b32 v150, v21, v21, v138
    v_perm_b32 v151, v21, v21, v139
    s_nop 1
    v_mfma_f32_16x16x32_bf16 v[152:155], v[148:151], v[44:47], v[152:155]
    v_perm_b32 v144, v22, v22, v136
    v_perm_b32 v145, v22, v22, v137
    v_perm_b32 v146, v22, v22, v138
    v_perm_b32 v147, v22, v22, v139
    s_nop 1
    v_mfma_f32_16x16x32_bf16 v[152:155], v[144:147], v[48:51], v[152:155]
    v_perm_b32 v148, v23, v23, v136
    v_perm_b32 v149, v23, v23, v137
    v_perm_b32 v150, v23, v23, v138
    v_perm_b32 v151, v23, v23, v139
    s_nop 1
    v_mfma_f32_16x16x32_bf16 v[152:155], v[148:151], v[52:55], v[152:155]
    v_perm_b32 v144, v24, v24, v136
    v_perm_b32 v145, v24, v24, v137
    v_perm_b32 v146, v24, v24, v138
    v_perm_b32 v147, v24, v24, v139
    s_nop 1
    v_mfma_f32_16x16x32_bf16 v[152:155], v[144:147], v[56:59], v[152:155]
    v_perm_b32 v148, v25, v25, v136
    v_perm_b32 v149, v25, v25, v137
    v_perm_b32 v150, v25, v25, v138
    v_perm_b32 v151, v25, v25, v139
    s_nop 1
    v_mfma_f32_16x16x32_bf16 v[152:155], v[148:151], v[60:63], v[152:155]
    v_perm_b32 v144, v26, v26, v136
    v_perm_b32 v145, v26, v26, v137
    v_perm_b32 v146, v26, v26, v138
    v_perm_b32 v147, v26, v26, v139
    s_nop 1
    v_mfma_f32_16x16x32_bf16 v[152:155], v[144:147], v[64:67], v[152:155]
    v_perm_b32 v148, v27, v27, v136
    v_perm_b32 v149, v27, v27, v137
    v_perm_b32 v150, v27, v27, v138
    v_perm_b32 v151, v27, v27, v139
    s_nop 1
    v_mfma_f32_16x16x32_bf16 v[152:155], v[148:151], v[68:71], v[152:155]
    v_lshlrev_b32 v16, 6, v1
    v_lshl_add_u32 v16, v2, 5, v16
    s_lshl_b32 s66, s68, 11
    s_lshl_b32 s67, s3, 9
    s_add_u32 s66, s66, s67
    s_add_u32 s66, s66, 65536
    v_mov_b32 v10, s56
    v_mov_b32 v11, s57
    v_mov_b32 v14, s56
    v_mov_b32 v15, s57
    v_mov_b32_dpp v144, v152 row_ror:8 row_mask:0xf bank_mask:0xf
    v_mov_b32_dpp v145, v153 row_ror:8 row_mask:0xf bank_mask:0xf
    v_mov_b32_dpp v146, v154 row_ror:8 row_mask:0xf bank_mask:0xf
    v_mov_b32_dpp v147, v155 row_ror:8 row_mask:0xf bank_mask:0xf
    v_permlane32_swap_b32 v144, v148
    v_permlane32_swap_b32 v145, v149
    v_permlane32_swap_b32 v146, v150
    v_permlane32_swap_b32 v147, v151
    v_add_f32 v8, v152, v148
    v_add_f32 v9, v153, v149
    v_add_f32 v12, v154, v150
    v_add_f32 v13, v155, v151
    s_mov_b32 s72, 0
    s_waitcnt vmcnt(1)
    v_xor_b32 v18, s79, v164
    v_xor_b32 v19, s56, v166
    v_or_b32 v18, v18, v19
    v_xor_b32 v19, s57, v167
    v_or_b32 v18, v18, v19
    v_cmp_ne_u32 vcc, 0, v18
    s_mov_b64 exec, 0x00ff00ff
    s_cbranch_vccz L_x1fast
    s_mov_b64 exec, -1
    s_waitcnt vmcnt(0)
    v_xor_b32 v18, s79, v160
    v_xor_b32 v19, s56, v162
    v_or_b32 v18, v18, v19
    v_xor_b32 v19, s57, v163
    v_or_b32 v18, v18, v19
    v_cmp_ne_u32 vcc, 0, v18
    s_mov_b64 exec, 0x00ff00ff
    s_cbranch_vccz L_x1fast
    buffer_store_dwordx4 v[8:11], v16, s[48:51], s66 offen sc1
    buffer_store_dwordx4 v[12:15], v16, s[48:51], s66 offen offset:16 sc1
    s_branch L_x1st
L_x1fast:
    s_mov_b32 s72, 1
    buffer_store_dwordx4 v[8:11], v16, s[48:51], s66 offen
    buffer_store_dwordx4 v[12:15], v16, s[48:51], s66 offen offset:16
L_x1st:
    s_mov_b64 exec, -1
    v_lshrrev_b32 v16, 5, v0
    v_lshlrev_b32 v16, 13, v16
    v_lshlrev_b32 v17, 11, v4
    s_cmp_ge_u32 s3, 2
    s_cbranch_scc1 L_pv_mlp
    v_and_b32 v18, 31, v0
    v_lshl_add_u32 v16, v18, 4, v16
    s_lshl_b32 s67, s3, 9
    v_add_u32 v16, s67, v16
    v_add_u32 v17, s67, v17
    s_branch L_pv_done
L_pv_mlp:
    v_bfe_u32 v18, v0, 4, 1
    v_lshl_add_u32 v16, v18, 9, v16
    v_lshl_add_u32 v16, v1, 4, v16
    s_and_b32 s67, s3, 1
    s_lshl_b32 s67, s67, 8
    s_add_u32 s67, s67, 1024
    v_add_u32 v16, s67, v16
    v_bfe_u32 v18, v0, 3, 1
    v_lshl_add_u32 v17, v18, 9, v17
    v_add_u32 v17, 1024, v17
L_pv_done:
    s_lshl_b32 s76, s4, 14
    s_add_u32 s76, s76, 65536
    s_add_u32 s77, s76, 4096
    s_sleep 6
    v_lshlrev_b32 v17, 4, v4
    s_mov_b32 s74, 0
    s_cmp_ge_u32 s3, 2
    s_cselect_b32 s73, 1000000, 1000000
L_x1try:
    s_mov_b32 s78, 0
    v_mov_b32 v48, s79
    v_mov_b32 v50, s56
    v_mov_b32 v51, s57
L_poll_x1:
    s_cmp_eq_u32 s72, 1
    s_cbranch_scc1 L_poll_x1f
    buffer_load_dwordx4 v[32:35], v16, s[48:51], s76 offen sc1
    buffer_load_dwordx4 v[36:39], v16, s[48:51], s76 offen offset:2048 sc1
    buffer_load_dwordx4 v[40:43], v16, s[48:51], s77 offen sc1
    buffer_load_dwordx4 v[44:47], v16, s[48:51], s77 offen offset:2048 sc1
    buffer_load_dwordx4 v[48:51], v17, s[48:51], s75 offen sc1
    s_branch L_poll_x1w
L_poll_x1f:
    buffer_load_dwordx4 v[32:35], v16, s[48:51], s76 offen nt
    buffer_load_dwordx4 v[36:39], v16, s[48:51], s76 offen offset:2048 nt
    buffer_load_dwordx4 v[40:43], v16, s[48:51], s77 offen nt
    buffer_load_dwordx4 v[44:47], v16, s[48:51], s77 offen offset:2048 nt
L_poll_x1w:
    s_waitcnt vmcnt(0)
    v_xor_b32 v19, s56, v34
    v_xor_b32 v18, s57, v35
    v_or_b32 v18, v18, v19
    v_xor_b32 v19, s56, v38
    v_or_b32 v18, v18, v19
    v_xor_b32 v19, s57, v39
    v_or_b32 v18, v18, v19
    v_xor_b32 v19, s56, v42
    v_or_b32 v18, v18, v19
    v_xor_b32 v19, s57, v43
    v_or_b32 v18, v18, v19
    v_xor_b32 v19, s56, v46
    v_or_b32 v18, v18, v19
    v_xor_b32 v19, s57, v47
    v_or_b32 v18, v18, v19
    v_xor_b32 v19, s56, v50
    v_or_b32 v18, v18, v19
    v_xor_b32 v19, s57, v51
    v_or_b32 v18, v18, v19
    v_cmp_ne_u32 vcc, 0, v18
    s_cbranch_vccz L_pdone_x1
    s_mov_b64 exec, vcc
    s_sleep 4
    s_add_u32 s78, s78, 1
    s_cmp_lt_u32 s78, s73
    s_cbranch_scc1 L_poll_x1
    s_mov_b64 exec, -1
    s_cmp_lt_u32 s3, 2
    s_cbranch_scc1 L_pdone_x1
    s_cmp_lg_u32 s74, 0
    s_cbranch_scc1 L_pdone_x1
    s_mov_b32 s74, 2
    s_branch L_barA
L_pdone_x1:
    s_mov_b64 exec, -1
    v_cmp_ne_u32 vcc, s79, v48
    s_cmp_eq_u64 vcc, 0
    s_cselect_b32 s79, 1, 0
    v_add_f32 v8, v32, v36
    v_add_f32 v9, v33, v37
    v_add_f32 v10, v40, v44
    v_add_f32 v11, v41, v45
    v_add_f32 v8, v8, v10
    v_add_f32 v9, v9, v11
    v_mov_b32 v10, v8
    v_mov_b32 v11, v9
    s_nop 0
    v_permlane32_swap_b32 v8, v10
    v_permlane32_swap_b32 v9, v11
    v_add_f32 v8, v8, v10
    v_add_f32 v9, v9, v11
    v_cvt_pk_bf16_f32 v10, v8, v9
    s_cmp_ge_u32 s3, 2
    s_cbranch_scc1 L_mlp
    v_and_b32 v17, 31, v0
    v_lshlrev_b32 v17, 2, v17
    s_lshl_b32 s67, s3, 7
    v_add_u32 v17, s67, v17
    ds_write_b32 v17, v10 offset:64
    v_mov_b32 v17, 0
    v_mov_b32 v18, 1
    s_waitcnt lgkmcnt(0)
    s_mov_b64 exec, 1
    ds_add_u32 v17, v18
    s_mov_b64 exec, -1
    v_mov_b32 v156, 0
    v_mov_b32 v157, 0
    v_mov_b32 v158, 0
    v_mov_b32 v159, 0
    s_branch L_mlp_done
L_mlp:
    v_lshlrev_b32 v8, 16, v10
    v_and_b32 v9, 0xffff0000, v10
    v_mov_b32 v11, v8
    v_mov_b32 v12, v9
    s_nop 0
    v_permlane16_swap_b32 v11, v13
    v_permlane16_swap_b32 v12, v14
    s_mov_b32 s67, 0x3fb8aa3b
    v_mul_f32 v8, s67, v8
    v_mul_f32 v9, s67, v9
    v_exp_f32 v8, -v8
    v_exp_f32 v9, -v9
    v_add_f32 v8, 1.0, v8
    v_add_f32 v9, 1.0, v9
    v_rcp_f32 v8, v8
    v_rcp_f32 v9, v9
    s_nop 0
    v_cvt_pk_bf16_f32 v10, v8, v9
    v_lshlrev_b32 v8, 16, v10
    v_and_b32 v9, 0xffff0000, v10
    v_mul_f32 v8, v8, v13
    v_mul_f32 v9, v9, v14
    v_cvt_pk_bf16_f32 v10, v8, v9
    s_and_b32 s67, s3, 1
    s_lshl_b32 s67, s67, 7
    s_add_u32 s67, s67, 512
    v_lshlrev_b32 v17, 2, v1
    v_add_u32 v17, s67, v17
    s_mov_b64 exec, 0xffff
    ds_write_b32 v17, v10
    s_mov_b64 exec, -1
    v_lshlrev_b32 v17, 1, v2
    v_add_u32 v17, s67, v17
    s_waitcnt lgkmcnt(0)
    ds_read_u16 v18, v17 offset:0
    ds_read_u16 v19, v17 offset:8
    ds_read_u16 v20, v17 offset:16
    ds_read_u16 v21, v17 offset:24
    ds_read_u16 v22, v17 offset:32
    ds_read_u16 v23, v17 offset:40
    ds_read_u16 v24, v17 offset:48
    ds_read_u16 v25, v17 offset:56
    s_waitcnt lgkmcnt(0)
    v_perm_b32 v144, v18, v18, v136
    v_perm_b32 v145, v18, v18, v137
    v_perm_b32 v146, v18, v18, v138
    v_perm_b32 v147, v18, v18, v139
    s_nop 1
    v_mfma_f32_16x16x32_bf16 v[156:159], v[144:147], v[72:75], 0
    v_perm_b32 v148, v19, v19, v136
    v_perm_b32 v149, v19, v19, v137
    v_perm_b32 v150, v19, v19, v138
    v_perm_b32 v151, v19, v19, v139
    s_nop 1
    v_mfma_f32_16x16x32_bf16 v[156:159], v[148:151], v[76:79], v[156:159]
    v_perm_b32 v144, v20, v20, v136
    v_perm_b32 v145, v20, v20, v137
    v_perm_b32 v146, v20, v20, v138
    v_perm_b32 v147, v20, v20, v139
    s_nop 1
    v_mfma_f32_16x16x32_bf16 v[156:159], v[144:147], v[80:83], v[156:159]
    v_perm_b32 v148, v21, v21, v136
    v_perm_b32 v149, v21, v21, v137
    v_perm_b32 v150, v21, v21, v138
    v_perm_b32 v151, v21, v21, v139
    s_nop 1
    v_mfma_f32_16x16x32_bf16 v[156:159], v[148:151], v[84:87], v[156:159]
    v_perm_b32 v144, v22, v22, v136
    v_perm_b32 v145, v22, v22, v137
    v_perm_b32 v146, v22, v22, v138
    v_perm_b32 v147, v22, v22, v139
    s_nop 1
    v_mfma_f32_16x16x32_bf16 v[156:159], v[144:147], v[88:91], v[156:159]
    v_perm_b32 v148, v23, v23, v136
    v_perm_b32 v149, v23, v23, v137
    v_perm_b32 v150, v23, v23, v138
    v_perm_b32 v151, v23, v23, v139
    s_nop 1
    v_mfma_f32_16x16x32_bf16 v[156:159], v[148:151], v[92:95], v[156:159]
    v_perm_b32 v144, v24, v24, v136
    v_perm_b32 v145, v24, v24, v137
    v_perm_b32 v146, v24, v24, v138
    v_perm_b32 v147, v24, v24, v139
    s_nop 1
    v_mfma_f32_16x16x32_bf16 v[156:159], v[144:147], v[96:99], v[156:159]
    v_perm_b32 v148, v25, v25, v136
    v_perm_b32 v149, v25, v25, v137
    v_perm_b32 v150, v25, v25, v138
    v_perm_b32 v151, v25, v25, v139
    s_nop 1
    v_mfma_f32_16x16x32_bf16 v[156:159], v[148:151], v[100:103], v[156:159]
    s_nop 7
L_mlp_done:
    s_cmp_eq_u32 s74, 1
    s_cbranch_scc1 L_afterA
L_barA:
    s_lshl_b32 s66, s4, 7
    s_lshl_b32 s67, s3, 5
    s_add_u32 s66, s66, s67
    s_mul_i32 s66, s66, 1280
    s_add_u32 s66, s66, s64
    s_setprio 0
    buffer_load_dwordx4 v[104:107], v6, s[44:47], s66 offen nt
    s_add_u32 s66, s66, 5120
    buffer_load_dwordx4 v[108:111], v6, s[44:47], s66 offen nt
    s_add_u32 s66, s66, 5120
    buffer_load_dwordx4 v[112:115], v6, s[44:47], s66 offen nt
    s_add_u32 s66, s66, 5120
    buffer_load_dwordx4 v[116:119], v6, s[44:47], s66 offen nt
    s_add_u32 s66, s66, 5120
    buffer_load_dwordx4 v[120:123], v6, s[44:47], s66 offen nt
    s_add_u32 s66, s66, 5120
    buffer_load_dwordx4 v[124:127], v6, s[44:47], s66 offen nt
    s_add_u32 s66, s66, 5120
    buffer_load_dwordx4 v[128:131], v6, s[44:47], s66 offen nt
    s_add_u32 s66, s66, 5120
    buffer_load_dwordx4 v[132:135], v6, s[44:47], s66 offen nt
    s_setprio 3
    s_cmp_lg_u32 s74, 2
    s_cbranch_scc1 L_afterA
    s_mov_b32 s74, 1
    s_mov_b32 s73, 1000000
    s_branch L_x1try
L_afterA:
    v_lshlrev_b32 v31, 5, v1
    v_lshl_add_u32 v31, v2, 4, v31
    s_lshl_b32 s67, s3, 9
    v_add_u32 v31, s67, v31
    s_mov_b32 exec_hi, 0
    ds_write_b128 v31, v[156:159] offset:8192
    s_mov_b64 exec, -1
    v_lshrrev_b32 v8, 2, v1
    v_and_b32 v9, 3, v1
    v_lshlrev_b32 v9, 3, v9
    v_add_u32 v8, v8, v9
    s_lshl_b32 s67, s3, 5
    v_add_u32 v8, s67, v8
    v_lshlrev_b32 v8, 2, v8
    v_mul_u32_u24 v9, 1056, v2
    v_add_u32 v9, 1024, v9
    v_add_u32 v8, v8, v9
    s_lshl_b32 s66, s68, 11
    s_lshl_b32 s67, s3, 9
    s_add_u32 s66, s66, s67
    s_add_u32 s69, s66, 1048576
    v_lshlrev_b32 v10, 11, v4
    v_bfe_u32 v11, v0, 3, 1
    v_lshlrev_b32 v11, 5, v11
    v_lshl_add_u32 v11, v2, 6, v11
    v_add_u32 v11, v10, v11
    s_lshl_b32 s72, s4, 14
    s_add_u32 s72, s72, s67
    s_add_u32 s72, s72, 1048576
    s_mov_b32 s73, 0x3fb8aa3b
    s_mul_i32 s67, s3, 80
    v_lshlrev_b32 v29, 2, v0
    v_add_u32 v29, s67, v29
    s_mul_i32 s66, s68, 1280
    s_mul_i32 s67, s3, 320
    s_add_u32 s66, s66, s67
    s_add_u32 s74, s66, 1572864
    v_mul_u32_u24 v5, 40960, v3
    v_lshl_add_u32 v5, v4, 4, v5
    s_mul_i32 s66, s5, 1280
    s_lshl_b32 s67, s4, 7
    s_add_u32 s66, s66, s67
    s_add_u32 s58, s66, 1572864
    s_add_u32 s59, s58, 10240
    s_add_u32 s60, s58, 20480
    s_add_u32 s61, s58, 30720
    v_mov_b32 v26, s56
    v_mov_b32 v27, s57
    v_and_b32 v17, 8, v0
    v_cmp_eq_u32 s[76:77], 8, v17
    v_cmp_eq_u32 s[62:63], 16, v0
    s_waitcnt lgkmcnt(0)
    s_barrier
    ds_read2_b32 v[12:13], v8 offset0:0 offset1:4
    ds_read2_b32 v[14:15], v8 offset0:132 offset1:136
    ds_read_b64 v[16:17], v9 offset:512
    ds_read_b64 v[18:19], v9 offset:1040
    s_waitcnt lgkmcnt(0)
    v_max_f32 v20, v16, v18
    v_mov_b32 v21, v20
    s_nop 1
    v_permlane16_swap_b32 v20, v21
    v_max_f32 v20, v20, v21
    v_mov_b32 v21, v20
    s_nop 1
    v_permlane32_swap_b32 v20, v21
    v_max_f32 v20, v20, v21
    v_sub_f32 v16, v16, v20
    v_sub_f32 v18, v18, v20
    v_mul_f32 v16, s73, v16
    v_mul_f32 v18, s73, v18
    v_exp_f32 v16, v16
    v_exp_f32 v18, v18
    v_mul_f32 v24, v16, v12
    v_mul_f32 v25, v16, v13
    v_mul_f32 v21, v16, v17
    v_fmac_f32 v24, v18, v14
    v_fmac_f32 v25, v18, v15
    v_fmac_f32 v21, v18, v19
    v_mov_b32 v12, v24
    v_mov_b32 v13, v25
    v_mov_b32 v14, v21
    v_permlane16_swap_b32 v24, v12
    v_permlane16_swap_b32 v25, v13
    v_permlane16_swap_b32 v21, v14
    v_add_f32 v24, v24, v12
    v_add_f32 v25, v25, v13
    v_add_f32 v21, v21, v14
    v_mov_b32 v12, v24
    v_mov_b32 v13, v25
    v_mov_b32 v14, v21
    v_permlane32_swap_b32 v24, v12
    v_permlane32_swap_b32 v25, v13
    v_permlane32_swap_b32 v21, v14
    v_add_f32 v24, v24, v12
    v_add_f32 v25, v25, v13
    v_add_f32 v21, v21, v14
    v_cndmask_b32 v24, v24, v20, s[62:63]
    v_cndmask_b32 v25, v25, v21, s[62:63]
    s_mov_b64 exec, 0x1ffff
    s_cmp_eq_u32 s79, 1
    s_cbranch_scc1 L_x3fast
    buffer_store_dwordx4 v[24:27], v7, s[48:51], s69 offen sc1
    s_branch L_x3st
L_x3fast:
    buffer_store_dwordx4 v[24:27], v7, s[48:51], s69 offen
L_x3st:
    s_mov_b64 exec, -1
    s_mov_b32 s78, 0
L_poll_x3:
    s_cmp_eq_u32 s79, 1
    s_cbranch_scc1 L_poll_x3f
    buffer_load_dwordx4 v[80:83], v11, s[48:51], s72 offen sc1
    buffer_load_dwordx4 v[84:87], v11, s[48:51], s72 offen offset:16 sc1
    buffer_load_dwordx4 v[88:91], v10, s[48:51], s72 offen offset:256 sc1
    s_branch L_poll_x3w
L_poll_x3f:
    buffer_load_dwordx4 v[80:83], v11, s[48:51], s72 offen nt
    buffer_load_dwordx4 v[84:87], v11, s[48:51], s72 offen offset:16 nt
    buffer_load_dwordx4 v[88:91], v10, s[48:51], s72 offen offset:256 nt
L_poll_x3w:
    s_waitcnt vmcnt(0)
    v_xor_b32 v18, s56, v82
    v_xor_b32 v17, s57, v83
    v_or_b32 v17, v17, v18
    v_xor_b32 v18, s56, v86
    v_or_b32 v17, v17, v18
    v_xor_b32 v18, s57, v87
    v_or_b32 v17, v17, v18
    v_xor_b32 v18, s56, v90
    v_or_b32 v17, v17, v18
    v_xor_b32 v18, s57, v91
    v_or_b32 v17, v17, v18
    v_cmp_ne_u32 vcc, 0, v17
    s_cbranch_vccz L_pdone_x3
    s_mov_b64 exec, vcc
    s_add_u32 s78, s78, 1
    s_cmp_lt_u32 s78, 1000000
    s_cbranch_scc1 L_poll_x3
L_pdone_x3:
    s_mov_b64 exec, -1
    v_mov_b32 v20, v88
    s_nop 1
    v_max_f32_dpp v20, v20, v20 quad_perm:[1,0,3,2] row_mask:0xf bank_mask:0xf
    s_nop 1
    v_max_f32_dpp v20, v20, v20 quad_perm:[2,3,0,1] row_mask:0xf bank_mask:0xf
    s_nop 1
    v_max_f32_dpp v20, v20, v20 row_half_mirror row_mask:0xf bank_mask:0xf
    v_sub_f32 v21, v88, v20
    v_mul_f32 v21, s73, v21
    v_exp_f32 v21, v21
    s_nop 0
    v_mul_f32 v12, v21, v80
    v_mul_f32 v13, v21, v81
    v_mul_f32 v14, v21, v84
    v_mul_f32 v15, v21, v85
    v_mul_f32 v16, v21, v89
    v_add_f32_dpp v12, v12, v12 quad_perm:[1,0,3,2] row_mask:0xf bank_mask:0xf
    v_add_f32_dpp v13, v13, v13 quad_perm:[1,0,3,2] row_mask:0xf bank_mask:0xf
    v_add_f32_dpp v14, v14, v14 quad_perm:[1,0,3,2] row_mask:0xf bank_mask:0xf
    v_add_f32_dpp v15, v15, v15 quad_perm:[1,0,3,2] row_mask:0xf bank_mask:0xf
    v_add_f32_dpp v16, v16, v16 quad_perm:[1,0,3,2] row_mask:0xf bank_mask:0xf
    v_add_f32_dpp v12, v12, v12 quad_perm:[2,3,0,1] row_mask:0xf bank_mask:0xf
    v_add_f32_dpp v13, v13, v13 quad_perm:[2,3,0,1] row_mask:0xf bank_mask:0xf
    v_add_f32_dpp v14, v14, v14 quad_perm:[2,3,0,1] row_mask:0xf bank_mask:0xf
    v_add_f32_dpp v15, v15, v15 quad_perm:[2,3,0,1] row_mask:0xf bank_mask:0xf
    v_add_f32_dpp v16, v16, v16 quad_perm:[2,3,0,1] row_mask:0xf bank_mask:0xf
    v_add_f32_dpp v12, v12, v12 row_half_mirror row_mask:0xf bank_mask:0xf
    v_add_f32_dpp v13, v13, v13 row_half_mirror row_mask:0xf bank_mask:0xf
    v_add_f32_dpp v14, v14, v14 row_half_mirror row_mask:0xf bank_mask:0xf
    v_add_f32_dpp v15, v15, v15 row_half_mirror row_mask:0xf bank_mask:0xf
    v_add_f32_dpp v16, v16, v16 row_half_mirror row_mask:0xf bank_mask:0xf
    v_rcp_f32 v16, v16
    s_nop 0
    v_mul_f32 v12, v12, v16
    v_mul_f32 v13, v13, v16
    v_mul_f32 v14, v14, v16
    v_mul_f32 v15, v15, v16
    v_cvt_pk_bf16_f32 v12, v12, v13
    v_cvt_pk_bf16_f32 v13, v14, v15
    s_nop 0
    v_mov_b32_dpp v14, v12 row_ror:8 row_mask:0xf bank_mask:0xf
    v_mov_b32_dpp v15, v13 row_ror:8 row_mask:0xf bank_mask:0xf
    v_cndmask_b32 v18, v12, v14, s[76:77]
    v_cndmask_b32 v19, v13, v15, s[76:77]
    v_cndmask_b32 v20, v14, v12, s[76:77]
    v_cndmask_b32 v21, v15, v13, s[76:77]
    v_perm_b32 v144, v18, v18, v136
    v_perm_b32 v145, v18, v18, v137
    v_perm_b32 v146, v18, v18, v138
    v_perm_b32 v147, v18, v18, v139
    v_perm_b32 v148, v18, v18, v140
    v_perm_b32 v149, v18, v18, v141
    v_perm_b32 v150, v18, v18, v142
    v_perm_b32 v151, v18, v18, v143
    v_mfma_f32_16x16x32_bf16 v[160:163], v[144:147], v[104:107], 0
    s_nop 0
    v_mfma_f32_16x16x32_bf16 v[160:163], v[148:151], v[108:111], v[160:163]
    v_perm_b32 v152, v19, v19, v136
    v_perm_b32 v153, v19, v19, v137
    v_perm_b32 v154, v19, v19, v138
    v_perm_b32 v155, v19, v19, v139
    v_perm_b32 v96, v19, v19, v140
    v_perm_b32 v97, v19, v19, v141
    v_perm_b32 v98, v19, v19, v142
    v_perm_b32 v99, v19, v19, v143
    v_mfma_f32_16x16x32_bf16 v[160:163], v[152:155], v[112:115], v[160:163]
    s_nop 0
    v_mfma_f32_16x16x32_bf16 v[160:163], v[96:99], v[116:119], v[160:163]
    v_perm_b32 v144, v20, v20, v136
    v_perm_b32 v145, v20, v20, v137
    v_perm_b32 v146, v20, v20, v138
    v_perm_b32 v147, v20, v20, v139
    v_perm_b32 v148, v20, v20, v140
    v_perm_b32 v149, v20, v20, v141
    v_perm_b32 v150, v20, v20, v142
    v_perm_b32 v151, v20, v20, v143
    v_mfma_f32_16x16x32_bf16 v[160:163], v[144:147], v[120:123], v[160:163]
    s_nop 0
    v_mfma_f32_16x16x32_bf16 v[160:163], v[148:151], v[124:127], v[160:163]
    v_perm_b32 v152, v21, v21, v136
    v_perm_b32 v153, v21, v21, v137
    v_perm_b32 v154, v21, v21, v138
    v_perm_b32 v155, v21, v21, v139
    v_perm_b32 v96, v21, v21, v140
    v_perm_b32 v97, v21, v21, v141
    v_perm_b32 v98, v21, v21, v142
    v_perm_b32 v99, v21, v21, v143
    v_mfma_f32_16x16x32_bf16 v[160:163], v[152:155], v[128:131], v[160:163]
    s_nop 0
    v_mfma_f32_16x16x32_bf16 v[160:163], v[96:99], v[132:135], v[160:163]
    s_mov_b32 exec_hi, 0
    s_nop 6
    ds_write_b128 v31, v[160:163] offset:6144
    s_mov_b64 exec, -1
    s_waitcnt lgkmcnt(0)
    s_barrier
    s_mov_b64 exec, 0xfffff
    ds_read_b32 v12, v29 offset:6144
    ds_read_b32 v13, v29 offset:6656
    ds_read_b32 v14, v29 offset:7168
    ds_read_b32 v15, v29 offset:7680
    ds_read_b32 v16, v29 offset:9216
    ds_read_b32 v17, v29 offset:9728
    s_waitcnt lgkmcnt(0)
    v_add_f32 v12, v12, v13
    v_add_f32 v14, v14, v15
    v_add_f32 v24, v12, v14
    v_add_f32 v25, v16, v17
    buffer_store_dwordx4 v[24:27], v7, s[48:51], s74 offen sc1
    s_mov_b64 exec, -1
    s_cmp_lg_u32 s3, 0
    s_cbranch_scc1 L_wdone
    s_cmp_ge_u32 s4, 10
    s_cbranch_scc1 L_wdone
    s_mov_b32 s78, 0
L_poll_x4:
    buffer_load_dwordx4 v[80:83], v5, s[48:51], s58 offen sc1
    buffer_load_dwordx4 v[84:87], v5, s[48:51], s59 offen sc1
    buffer_load_dwordx4 v[88:91], v5, s[48:51], s60 offen sc1
    buffer_load_dwordx4 v[92:95], v5, s[48:51], s61 offen sc1
    s_waitcnt vmcnt(0)
    v_xor_b32 v18, s56, v82
    v_xor_b32 v17, s57, v83
    v_or_b32 v17, v17, v18
    v_xor_b32 v18, s56, v86
    v_or_b32 v17, v17, v18
    v_xor_b32 v18, s57, v87
    v_or_b32 v17, v17, v18
    v_xor_b32 v18, s56, v90
    v_or_b32 v17, v17, v18
    v_xor_b32 v18, s57, v91
    v_or_b32 v17, v17, v18
    v_xor_b32 v18, s56, v94
    v_or_b32 v17, v17, v18
    v_xor_b32 v18, s57, v95
    v_or_b32 v17, v17, v18
    v_cmp_ne_u32 vcc, 0, v17
    s_cbranch_vccz L_pdone_x4
    s_mov_b64 exec, vcc
    s_add_u32 s78, s78, 1
    s_cmp_lt_u32 s78, 1000000
    s_cbranch_scc1 L_poll_x4
L_pdone_x4:
    s_mov_b64 exec, -1
    v_add_f32 v8, v80, v84
    v_add_f32 v9, v81, v85
    v_add_f32 v10, v88, v92
    v_add_f32 v11, v89, v93
    v_add_f32 v8, v8, v10
    v_add_f32 v9, v9, v11
    s_nop 0
    v_add_f32_dpp v8, v8, v8 row_ror:8 row_mask:0xf bank_mask:0xf
    v_add_f32_dpp v9, v9, v9 row_ror:8 row_mask:0xf bank_mask:0xf
    v_mov_b32 v10, v8
    v_mov_b32 v11, v9
    s_nop 0
    v_permlane16_swap_b32 v8, v10
    v_permlane16_swap_b32 v9, v11
    v_add_f32 v8, v8, v10
    v_add_f32 v9, v9, v11
    v_mov_b32 v10, v8
    v_mov_b32 v11, v9
    s_nop 0
    v_permlane32_swap_b32 v8, v10
    v_permlane32_swap_b32 v9, v11
    v_add_f32 v8, v8, v10
    v_add_f32 v9, v9, v11
    v_cvt_pk_bf16_f32 v10, v8, v9
    v_lshlrev_b32 v8, 16, v10
    v_and_b32 v9, 0xffff0000, v10
    v_lshlrev_b32 v11, 16, v28
    v_add_f32 v8, v11, v8
    v_cvt_pk_bf16_f32 v8, v8, v8
    v_and_b32 v8, 0xffff0000, v8
    v_add_f32 v8, v8, v9
    v_cvt_pk_bf16_f32 v8, v8, v8
    s_mov_b64 exec, 0xff
    buffer_store_short v8, v30, s[52:55], s65 offen
    s_cmp_lg_u32 s2, 0
    s_cbranch_scc1 L_wdone
    s_mov_b64 exec, 1
    v_mov_b32 v8, s56
    v_mov_b32 v9, s57
    buffer_store_dwordx2 v[8:9], off, s[48:51], 0 sc1
L_wdone:
    s_mov_b64 exec, -1
    s_branch L_end
L_kv:
    s_setprio 2
    v_lshlrev_b32 v1, 4, v0
    s_lshl_b32 s58, s4, 23
    s_add_u32 s58, s58, 0x700000
    s_lshl_b32 s59, s5, 17
    s_add_u32 s58, s58, s59
    s_mul_i32 s59, s4, 9
    s_mul_i32 s60, s5, 5
    s_add_u32 s59, s59, s60
    s_sub_u32 s60, s3, 4
    s_lshl_b32 s60, s60, 2
    s_add_u32 s59, s59, s60
    s_add_u32 s60, s59, 0
    s_and_b32 s60, s60, 31
    s_lshl_b32 s60, s60, 12
    s_add_u32 s64, s60, s58
    s_add_u32 s60, s59, 1
    s_and_b32 s60, s60, 31
    s_lshl_b32 s60, s60, 12
    s_add_u32 s65, s60, s58
    s_add_u32 s60, s59, 2
    s_and_b32 s60, s60, 31
    s_lshl_b32 s60, s60, 12
    s_add_u32 s66, s60, s58
    s_add_u32 s60, s59, 3
    s_and_b32 s60, s60, 31
    s_lshl_b32 s60, s60, 12
    s_add_u32 s67, s60, s58
    s_waitcnt lgkmcnt(0)
    s_barrier
    s_mov_b32 s32, s10
    s_mov_b32 s33, s11
    s_mov_b32 s34, 268435456
    s_mov_b32 s35, 0x00020000
    s_mov_b32 s36, s12
    s_mov_b32 s37, s13
    s_mov_b32 s38, 268435456
    s_mov_b32 s39, 0x00020000
    buffer_load_dwordx4 v[8:11], v1, s[32:35], s64 offen offset:0 nt
    buffer_load_dwordx4 v[12:15], v1, s[32:35], s64 offen offset:1024 nt
    buffer_load_dwordx4 v[16:19], v1, s[32:35], s64 offen offset:2048 nt
    buffer_load_dwordx4 v[20:23], v1, s[32:35], s64 offen offset:3072 nt
    buffer_load_dwordx4 v[24:27], v1, s[32:35], s65 offen offset:0 nt
    buffer_load_dwordx4 v[28:31], v1, s[32:35], s65 offen offset:1024 nt
    buffer_load_dwordx4 v[32:35], v1, s[32:35], s65 offen offset:2048 nt
    buffer_load_dwordx4 v[36:39], v1, s[32:35], s65 offen offset:3072 nt
    buffer_load_dwordx4 v[40:43], v1, s[32:35], s66 offen offset:0 nt
    buffer_load_dwordx4 v[44:47], v1, s[32:35], s66 offen offset:1024 nt
    buffer_load_dwordx4 v[48:51], v1, s[32:35], s66 offen offset:2048 nt
    buffer_load_dwordx4 v[52:55], v1, s[32:35], s66 offen offset:3072 nt
    buffer_load_dwordx4 v[56:59], v1, s[32:35], s67 offen offset:0 nt
    buffer_load_dwordx4 v[60:63], v1, s[32:35], s67 offen offset:1024 nt
    buffer_load_dwordx4 v[64:67], v1, s[32:35], s67 offen offset:2048 nt
    buffer_load_dwordx4 v[68:71], v1, s[32:35], s67 offen offset:3072 nt
    s_setprio 1
    buffer_load_dwordx4 v[72:75], v1, s[36:39], s64 offen offset:0 nt
    buffer_load_dwordx4 v[76:79], v1, s[36:39], s64 offen offset:1024 nt
    buffer_load_dwordx4 v[80:83], v1, s[36:39], s64 offen offset:2048 nt
    buffer_load_dwordx4 v[84:87], v1, s[36:39], s64 offen offset:3072 nt
    buffer_load_dwordx4 v[88:91], v1, s[36:39], s65 offen offset:0 nt
    buffer_load_dwordx4 v[92:95], v1, s[36:39], s65 offen offset:1024 nt
    buffer_load_dwordx4 v[96:99], v1, s[36:39], s65 offen offset:2048 nt
    buffer_load_dwordx4 v[100:103], v1, s[36:39], s65 offen offset:3072 nt
    buffer_load_dwordx4 v[104:107], v1, s[36:39], s66 offen offset:0 nt
    buffer_load_dwordx4 v[108:111], v1, s[36:39], s66 offen offset:1024 nt
    buffer_load_dwordx4 v[112:115], v1, s[36:39], s66 offen offset:2048 nt
    buffer_load_dwordx4 v[116:119], v1, s[36:39], s66 offen offset:3072 nt
    buffer_load_dwordx4 v[120:123], v1, s[36:39], s67 offen offset:0 nt
    buffer_load_dwordx4 v[124:127], v1, s[36:39], s67 offen offset:1024 nt
    buffer_load_dwordx4 v[128:131], v1, s[36:39], s67 offen offset:2048 nt
    buffer_load_dwordx4 v[132:135], v1, s[36:39], s67 offen offset:3072 nt
    v_and_b32 v3, 15, v0
    v_lshrrev_b32 v4, 4, v0
    v_and_b32 v5, 1, v0
    v_cmp_eq_u32 vcc, 1, v5
    v_mov_b32 v6, 0x0c0c0100
    v_mov_b32 v7, 0x01000c0c
    v_cndmask_b32 v6, v6, v7, vcc
    v_mov_b32 v5, 0x0c0c0302
    v_mov_b32 v7, 0x03020c0c
    v_cndmask_b32 v7, v5, v7, vcc
    v_and_b32 v5, 8, v0
    v_cmp_eq_u32 vcc, 8, v5
    s_nop 1
    v_cndmask_b32 v6, v6, v7, vcc
    v_bfe_u32 v5, v0, 1, 2
    v_cmp_eq_u32 vcc, 0, v5
    v_mov_b32 v140, 0x0c0c0c0c
    s_nop 0
    v_cndmask_b32 v140, v140, v6, vcc
    v_cmp_eq_u32 vcc, 1, v5
    v_mov_b32 v141, 0x0c0c0c0c
    s_nop 0
    v_cndmask_b32 v141, v141, v6, vcc
    v_cmp_eq_u32 vcc, 2, v5
    v_mov_b32 v142, 0x0c0c0c0c
    s_nop 0
    v_cndmask_b32 v142, v142, v6, vcc
    v_cmp_eq_u32 vcc, 3, v5
    v_mov_b32 v143, 0x0c0c0c0c
    s_nop 0
    v_cndmask_b32 v143, v143, v6, vcc
    v_mov_b32 v5, 0
    s_mov_b32 s78, 0
L_qspin:
    ds_read_b32 v6, v5
    s_waitcnt lgkmcnt(0)
    v_readfirstlane_b32 s60, v6
    s_cmp_ge_u32 s60, 2
    s_cbranch_scc1 L_qok
    s_sleep 2
    s_add_u32 s78, s78, 1
    s_cmp_lt_u32 s78, 0x4000000
    s_cbranch_scc1 L_qspin
L_qok:
    v_lshlrev_b32 v5, 4, v3
    ds_read_b128 v[136:139], v5 offset:64
    s_waitcnt lgkmcnt(0)
    s_waitcnt vmcnt(28)
    v_dot2_f32_bf16 v152, v8, v136, 0
    v_dot2_f32_bf16 v153, v12, v136, 0
    v_dot2_f32_bf16 v154, v16, v136, 0
    v_dot2_f32_bf16 v155, v20, v136, 0
    v_dot2_f32_bf16 v152, v9, v137, v152
    v_dot2_f32_bf16 v153, v13, v137, v153
    v_dot2_f32_bf16 v154, v17, v137, v154
    v_dot2_f32_bf16 v155, v21, v137, v155
    v_dot2_f32_bf16 v152, v10, v138, v152
    v_dot2_f32_bf16 v153, v14, v138, v153
    v_dot2_f32_bf16 v154, v18, v138, v154
    v_dot2_f32_bf16 v155, v22, v138, v155
    v_dot2_f32_bf16 v152, v11, v139, v152
    v_dot2_f32_bf16 v153, v15, v139, v153
    v_dot2_f32_bf16 v154, v19, v139, v154
    v_dot2_f32_bf16 v155, v23, v139, v155
    s_waitcnt vmcnt(24)
    v_dot2_f32_bf16 v156, v24, v136, 0
    v_dot2_f32_bf16 v157, v28, v136, 0
    v_dot2_f32_bf16 v158, v32, v136, 0
    v_dot2_f32_bf16 v159, v36, v136, 0
    v_dot2_f32_bf16 v156, v25, v137, v156
    v_dot2_f32_bf16 v157, v29, v137, v157
    v_dot2_f32_bf16 v158, v33, v137, v158
    v_dot2_f32_bf16 v159, v37, v137, v159
    v_dot2_f32_bf16 v156, v26, v138, v156
    v_dot2_f32_bf16 v157, v30, v138, v157
    v_dot2_f32_bf16 v158, v34, v138, v158
    v_dot2_f32_bf16 v159, v38, v138, v159
    v_dot2_f32_bf16 v156, v27, v139, v156
    v_dot2_f32_bf16 v157, v31, v139, v157
    v_dot2_f32_bf16 v158, v35, v139, v158
    v_dot2_f32_bf16 v159, v39, v139, v159
    s_waitcnt vmcnt(20)
    v_dot2_f32_bf16 v160, v40, v136, 0
    v_dot2_f32_bf16 v161, v44, v136, 0
    v_dot2_f32_bf16 v162, v48, v136, 0
    v_dot2_f32_bf16 v163, v52, v136, 0
    v_dot2_f32_bf16 v160, v41, v137, v160
    v_dot2_f32_bf16 v161, v45, v137, v161
    v_dot2_f32_bf16 v162, v49, v137, v162
    v_dot2_f32_bf16 v163, v53, v137, v163
    v_dot2_f32_bf16 v160, v42, v138, v160
    v_dot2_f32_bf16 v161, v46, v138, v161
    v_dot2_f32_bf16 v162, v50, v138, v162
    v_dot2_f32_bf16 v163, v54, v138, v163
    v_dot2_f32_bf16 v160, v43, v139, v160
    v_dot2_f32_bf16 v161, v47, v139, v161
    v_dot2_f32_bf16 v162, v51, v139, v162
    v_dot2_f32_bf16 v163, v55, v139, v163
    s_waitcnt vmcnt(16)
    v_dot2_f32_bf16 v164, v56, v136, 0
    v_dot2_f32_bf16 v165, v60, v136, 0
    v_dot2_f32_bf16 v166, v64, v136, 0
    v_dot2_f32_bf16 v167, v68, v136, 0
    v_dot2_f32_bf16 v164, v57, v137, v164
    v_dot2_f32_bf16 v165, v61, v137, v165
    v_dot2_f32_bf16 v166, v65, v137, v166
    v_dot2_f32_bf16 v167, v69, v137, v167
    v_dot2_f32_bf16 v164, v58, v138, v164
    v_dot2_f32_bf16 v165, v62, v138, v165
    v_dot2_f32_bf16 v166, v66, v138, v166
    v_dot2_f32_bf16 v167, v70, v138, v167
    v_dot2_f32_bf16 v164, v59, v139, v164
    v_dot2_f32_bf16 v165, v63, v139, v165
    v_dot2_f32_bf16 v166, v67, v139, v166
    v_dot2_f32_bf16 v167, v71, v139, v167
    v_add_f32_dpp v152, v152, v152 row_ror:8 row_mask:0xf bank_mask:0x3
    v_add_f32_dpp v153, v153, v153 row_ror:8 row_mask:0xf bank_mask:0x3
    v_add_f32_dpp v154, v154, v154 row_ror:8 row_mask:0xf bank_mask:0x3
    v_add_f32_dpp v155, v155, v155 row_ror:8 row_mask:0xf bank_mask:0x3
    v_add_f32_dpp v156, v156, v156 row_ror:8 row_mask:0xf bank_mask:0x3
    v_add_f32_dpp v157, v157, v157 row_ror:8 row_mask:0xf bank_mask:0x3
    v_add_f32_dpp v158, v158, v158 row_ror:8 row_mask:0xf bank_mask:0x3
    v_add_f32_dpp v159, v159, v159 row_ror:8 row_mask:0xf bank_mask:0x3
    v_add_f32_dpp v152, v160, v160 row_ror:8 row_mask:0xf bank_mask:0xc
    v_add_f32_dpp v153, v161, v161 row_ror:8 row_mask:0xf bank_mask:0xc
    v_add_f32_dpp v154, v162, v162 row_ror:8 row_mask:0xf bank_mask:0xc
    v_add_f32_dpp v155, v163, v163 row_ror:8 row_mask:0xf bank_mask:0xc
    v_add_f32_dpp v156, v164, v164 row_ror:8 row_mask:0xf bank_mask:0xc
    v_add_f32_dpp v157, v165, v165 row_ror:8 row_mask:0xf bank_mask:0xc
    v_add_f32_dpp v158, v166, v166 row_ror:8 row_mask:0xf bank_mask:0xc
    v_add_f32_dpp v159, v167, v167 row_ror:8 row_mask:0xf bank_mask:0xc
    v_add_f32_dpp v152, v152, v152 row_shl:4 row_mask:0xf bank_mask:0x5
    v_add_f32_dpp v153, v153, v153 row_shl:4 row_mask:0xf bank_mask:0x5
    v_add_f32_dpp v154, v154, v154 row_shl:4 row_mask:0xf bank_mask:0x5
    v_add_f32_dpp v155, v155, v155 row_shl:4 row_mask:0xf bank_mask:0x5
    v_add_f32_dpp v152, v156, v156 row_shr:4 row_mask:0xf bank_mask:0xa
    v_add_f32_dpp v153, v157, v157 row_shr:4 row_mask:0xf bank_mask:0xa
    v_add_f32_dpp v154, v158, v158 row_shr:4 row_mask:0xf bank_mask:0xa
    v_add_f32_dpp v155, v159, v159 row_shr:4 row_mask:0xf bank_mask:0xa
    v_and_b32 v5, 2, v0
    v_cmp_eq_u32 vcc, 2, v5
    v_add_f32_dpp v152, v152, v152 quad_perm:[2,3,0,1] row_mask:0xf bank_mask:0xf
    v_add_f32_dpp v153, v153, v153 quad_perm:[2,3,0,1] row_mask:0xf bank_mask:0xf
    v_add_f32_dpp v154, v154, v154 quad_perm:[2,3,0,1] row_mask:0xf bank_mask:0xf
    v_add_f32_dpp v155, v155, v155 quad_perm:[2,3,0,1] row_mask:0xf bank_mask:0xf
    v_cndmask_b32 v152, v152, v154, vcc
    v_cndmask_b32 v153, v153, v155, vcc
    v_and_b32 v5, 1, v0
    v_cmp_eq_u32 vcc, 1, v5
    v_add_f32_dpp v152, v152, v152 quad_perm:[1,0,3,2] row_mask:0xf bank_mask:0xf
    v_add_f32_dpp v153, v153, v153 quad_perm:[1,0,3,2] row_mask:0xf bank_mask:0xf
    v_cndmask_b32 v152, v152, v153, vcc
    s_mov_b32 s60, 0x3db504f3
    s_mov_b32 s61, 0x3fb8aa3b
    v_cvt_pk_bf16_f32 v152, v152, v152
    v_and_b32 v152, 0xffff0000, v152
    v_mul_f32 v152, s60, v152
    v_cvt_pk_bf16_f32 v152, v152, v152
    v_and_b32 v152, 0xffff0000, v152
    v_mov_b32 v156, v152
    s_nop 1
    v_max_f32_dpp v156, v156, v156 row_ror:8 row_mask:0xf bank_mask:0xf
    s_nop 1
    v_max_f32_dpp v156, v156, v156 row_ror:4 row_mask:0xf bank_mask:0xf
    s_nop 1
    v_max_f32_dpp v156, v156, v156 row_ror:2 row_mask:0xf bank_mask:0xf
    s_nop 1
    v_max_f32_dpp v156, v156, v156 row_ror:1 row_mask:0xf bank_mask:0xf
    v_mov_b32 v144, v156
    s_nop 1
    v_permlane16_swap_b32 v156, v144
    v_max_f32 v156, v156, v144
    v_mov_b32 v144, v156
    s_nop 1
    v_permlane32_swap_b32 v156, v144
    v_max_f32 v156, v156, v144
    v_sub_f32 v158, v152, v156
    v_mul_f32 v158, s61, v158
    v_exp_f32 v158, v158
    s_nop 0
    v_cvt_pk_bf16_f32 v144, v158, v158
    v_and_b32 v144, 0xffff0000, v144
    v_sub_f32 v144, v158, v144
    v_cvt_pk_bf16_f32 v159, v158, v144
    s_nop 1
    v_mov_b32_dpp v144, v159 row_newbcast:0 row_mask:0xf bank_mask:0xf
    v_perm_b32 v8, v144, v144, v140
    v_perm_b32 v9, v144, v144, v141
    v_perm_b32 v10, v144, v144, v142
    v_perm_b32 v11, v144, v144, v143
    v_mov_b32_dpp v145, v159 row_newbcast:1 row_mask:0xf bank_mask:0xf
    v_perm_b32 v12, v145, v145, v140
    v_perm_b32 v13, v145, v145, v141
    v_perm_b32 v14, v145, v145, v142
    v_perm_b32 v15, v145, v145, v143
    v_mov_b32_dpp v146, v159 row_newbcast:2 row_mask:0xf bank_mask:0xf
    v_perm_b32 v16, v146, v146, v140
    v_perm_b32 v17, v146, v146, v141
    v_perm_b32 v18, v146, v146, v142
    v_perm_b32 v19, v146, v146, v143
    v_mov_b32_dpp v147, v159 row_newbcast:3 row_mask:0xf bank_mask:0xf
    v_perm_b32 v20, v147, v147, v140
    v_perm_b32 v21, v147, v147, v141
    v_perm_b32 v22, v147, v147, v142
    v_perm_b32 v23, v147, v147, v143
    v_mov_b32_dpp v144, v159 row_newbcast:4 row_mask:0xf bank_mask:0xf
    v_perm_b32 v24, v144, v144, v140
    v_perm_b32 v25, v144, v144, v141
    v_perm_b32 v26, v144, v144, v142
    v_perm_b32 v27, v144, v144, v143
    v_mov_b32_dpp v145, v159 row_newbcast:5 row_mask:0xf bank_mask:0xf
    v_perm_b32 v28, v145, v145, v140
    v_perm_b32 v29, v145, v145, v141
    v_perm_b32 v30, v145, v145, v142
    v_perm_b32 v31, v145, v145, v143
    v_mov_b32_dpp v146, v159 row_newbcast:6 row_mask:0xf bank_mask:0xf
    v_perm_b32 v32, v146, v146, v140
    v_perm_b32 v33, v146, v146, v141
    v_perm_b32 v34, v146, v146, v142
    v_perm_b32 v35, v146, v146, v143
    v_mov_b32_dpp v147, v159 row_newbcast:7 row_mask:0xf bank_mask:0xf
    v_perm_b32 v36, v147, v147, v140
    v_perm_b32 v37, v147, v147, v141
    v_perm_b32 v38, v147, v147, v142
    v_perm_b32 v39, v147, v147, v143
    v_mov_b32_dpp v144, v159 row_newbcast:8 row_mask:0xf bank_mask:0xf
    v_perm_b32 v40, v144, v144, v140
    v_perm_b32 v41, v144, v144, v141
    v_perm_b32 v42, v144, v144, v142
    v_perm_b32 v43, v144, v144, v143
    v_mov_b32_dpp v145, v159 row_newbcast:9 row_mask:0xf bank_mask:0xf
    v_perm_b32 v44, v145, v145, v140
    v_perm_b32 v45, v145, v145, v141
    v_perm_b32 v46, v145, v145, v142
    v_perm_b32 v47, v145, v145, v143
    v_mov_b32_dpp v146, v159 row_newbcast:10 row_mask:0xf bank_mask:0xf
    v_perm_b32 v48, v146, v146, v140
    v_perm_b32 v49, v146, v146, v141
    v_perm_b32 v50, v146, v146, v142
    v_perm_b32 v51, v146, v146, v143
    v_mov_b32_dpp v147, v159 row_newbcast:11 row_mask:0xf bank_mask:0xf
    v_perm_b32 v52, v147, v147, v140
    v_perm_b32 v53, v147, v147, v141
    v_perm_b32 v54, v147, v147, v142
    v_perm_b32 v55, v147, v147, v143
    v_mov_b32_dpp v144, v159 row_newbcast:12 row_mask:0xf bank_mask:0xf
    v_perm_b32 v56, v144, v144, v140
    v_perm_b32 v57, v144, v144, v141
    v_perm_b32 v58, v144, v144, v142
    v_perm_b32 v59, v144, v144, v143
    v_mov_b32_dpp v145, v159 row_newbcast:13 row_mask:0xf bank_mask:0xf
    v_perm_b32 v60, v145, v145, v140
    v_perm_b32 v61, v145, v145, v141
    v_perm_b32 v62, v145, v145, v142
    v_perm_b32 v63, v145, v145, v143
    v_mov_b32_dpp v146, v159 row_newbcast:14 row_mask:0xf bank_mask:0xf
    v_perm_b32 v64, v146, v146, v140
    v_perm_b32 v65, v146, v146, v141
    v_perm_b32 v66, v146, v146, v142
    v_perm_b32 v67, v146, v146, v143
    v_mov_b32_dpp v147, v159 row_newbcast:15 row_mask:0xf bank_mask:0xf
    v_perm_b32 v68, v147, v147, v140
    v_perm_b32 v69, v147, v147, v141
    v_perm_b32 v70, v147, v147, v142
    v_perm_b32 v71, v147, v147, v143
    v_mov_b32 v157, v158
    s_nop 1
    v_add_f32_dpp v157, v157, v157 row_ror:8 row_mask:0xf bank_mask:0xf
    s_nop 1
    v_add_f32_dpp v157, v157, v157 row_ror:4 row_mask:0xf bank_mask:0xf
    s_nop 1
    v_add_f32_dpp v157, v157, v157 row_ror:2 row_mask:0xf bank_mask:0xf
    s_nop 1
    v_add_f32_dpp v157, v157, v157 row_ror:1 row_mask:0xf bank_mask:0xf
    v_mov_b32 v144, v157
    s_nop 1
    v_permlane16_swap_b32 v157, v144
    v_add_f32 v157, v157, v144
    v_mov_b32 v144, v157
    s_nop 1
    v_permlane32_swap_b32 v157, v144
    v_add_f32 v157, v157, v144
    s_sub_u32 s60, s3, 4
    s_mul_i32 s60, s60, 528
    s_add_u32 s60, s60, 1024
    v_lshlrev_b32 v5, 5, v3
    v_lshl_add_u32 v5, v4, 4, v5
    v_add_u32 v5, s60, v5
    v_mov_b32 v6, s60
    s_mov_b64 exec, 1
    ds_write_b64 v6, v[156:157] offset:512
    s_mov_b64 exec, -1
    s_waitcnt vmcnt(15)
    v_mfma_f32_16x16x32_bf16 v[160:163], v[8:11], v[72:75], 0
    s_waitcnt vmcnt(14)
    v_mfma_f32_16x16x32_bf16 v[160:163], v[12:15], v[76:79], v[160:163]
    s_waitcnt vmcnt(13)
    v_mfma_f32_16x16x32_bf16 v[160:163], v[16:19], v[80:83], v[160:163]
    s_waitcnt vmcnt(12)
    v_mfma_f32_16x16x32_bf16 v[160:163], v[20:23], v[84:87], v[160:163]
    s_waitcnt vmcnt(11)
    v_mfma_f32_16x16x32_bf16 v[160:163], v[24:27], v[88:91], v[160:163]
    s_waitcnt vmcnt(10)
    v_mfma_f32_16x16x32_bf16 v[160:163], v[28:31], v[92:95], v[160:163]
    s_waitcnt vmcnt(9)
    v_mfma_f32_16x16x32_bf16 v[160:163], v[32:35], v[96:99], v[160:163]
    s_waitcnt vmcnt(8)
    v_mfma_f32_16x16x32_bf16 v[160:163], v[36:39], v[100:103], v[160:163]
    s_waitcnt vmcnt(7)
    v_mfma_f32_16x16x32_bf16 v[160:163], v[40:43], v[104:107], v[160:163]
    s_waitcnt vmcnt(6)
    v_mfma_f32_16x16x32_bf16 v[160:163], v[44:47], v[108:111], v[160:163]
    s_waitcnt vmcnt(5)
    v_mfma_f32_16x16x32_bf16 v[160:163], v[48:51], v[112:115], v[160:163]
    s_waitcnt vmcnt(4)
    v_mfma_f32_16x16x32_bf16 v[160:163], v[52:55], v[116:119], v[160:163]
    s_waitcnt vmcnt(3)
    v_mfma_f32_16x16x32_bf16 v[160:163], v[56:59], v[120:123], v[160:163]
    s_waitcnt vmcnt(2)
    v_mfma_f32_16x16x32_bf16 v[160:163], v[60:63], v[124:127], v[160:163]
    s_waitcnt vmcnt(1)
    v_mfma_f32_16x16x32_bf16 v[160:163], v[64:67], v[128:131], v[160:163]
    s_waitcnt vmcnt(0)
    v_mfma_f32_16x16x32_bf16 v[160:163], v[68:71], v[132:135], v[160:163]
    s_nop 7
    v_mov_b32 v144, v160
    v_mov_b32 v145, v161
    v_mov_b32 v146, v162
    v_mov_b32 v147, v163
    v_permlane32_swap_b32 v160, v144
    v_permlane32_swap_b32 v161, v145
    v_permlane32_swap_b32 v162, v146
    v_permlane32_swap_b32 v163, v147
    v_add_f32 v160, v160, v144
    v_add_f32 v161, v161, v145
    v_add_f32 v162, v162, v146
    v_add_f32 v163, v163, v147
    s_mov_b32 exec_hi, 0
    ds_write_b128 v5, v[160:163]
    s_mov_b64 exec, -1
    s_waitcnt lgkmcnt(0)
    s_barrier
L_end:
    s_endpgm
.p2align 10
L_codeend:
.section .rodata,"a"
.p2align 6
.amdhsa_kernel parallel_sum__sliding_block_cached__glu_gated_glu__decode_kernel
  .amdhsa_next_free_vgpr 168
  .amdhsa_next_free_sgpr 96
  .amdhsa_accum_offset 168
  .amdhsa_group_segment_fixed_size 0
  .amdhsa_kernarg_size 96
  .amdhsa_user_sgpr_count 2
  .amdhsa_user_sgpr_kernarg_segment_ptr 1
  .amdhsa_system_sgpr_workgroup_id_x 1
.end_amdhsa_kernel
```
